```python
import torch

def _softmax(x, axis=-1):
    return torch.softmax(x, dim=axis)
def _gelu(x):
    return torch.nn.functional.gelu(x, approximate="tanh")
def _silu(x):
    return torch.nn.functional.silu(x)
def _sigmoid(x):
    return torch.sigmoid(x)
def _layernorm(x, axis=-1, eps=1e-5):
    m = x.mean(dim=axis, keepdim=True)
    v = x.var(dim=axis, keepdim=True, unbiased=False)
    return (x - m) / torch.sqrt(v + eps)
def _scatter_add(tgt, idx, src, axis=0):
    return tgt.clone().index_add_(axis, idx, src)
def _segment_sum(src, seg, n):
    out = torch.zeros((n,) + src.shape[1:], dtype=src.dtype)
    return out.index_add_(0, seg, src)
def _pad(x, pw):
    flat = tuple(v for pair in reversed(pw) for v in pair)
    return torch.nn.functional.pad(x, flat)

kernel_name = 'standalone__spectral_fnet__prompt'

def setup_inputs():

    _w = (lambda a: (lambda t: t.to(torch.bfloat16) if t.is_floating_point() else t)(torch.as_tensor(a)))
    B, S, D = 1, 2048, 576
    ns = torch.arange(S)[:, None] * torch.arange(S)[None, :]
    nd = torch.arange(D)[:, None] * torch.arange(D)[None, :]
    Ws_re = torch.cos(-2.0 * torch.pi * ns / S).to(float)
    Ws_im = torch.sin(-2.0 * torch.pi * ns / S).to(float)
    Wd_re = torch.cos(-2.0 * torch.pi * nd / D).to(float)
    Wd_im = torch.sin(-2.0 * torch.pi * nd / D).to(float)
    return {
        "x": _w((lambda *s: torch.randn(*s, dtype=torch.bfloat16) * 0.05)(B, S, D)),
        "dft_seq_re": _w(Ws_re),
        "dft_seq_im": _w(Ws_im),
        "dft_hid_re": _w(Wd_re),
        "dft_hid_im": _w(Wd_im),
    }

def reference(x, dft_seq_re, dft_seq_im, dft_hid_re, dft_hid_im):
    a = torch.einsum("bsd,ed->bse", x, dft_hid_re)
    b = torch.einsum("bsd,ed->bse", x, dft_hid_im)
    y = torch.einsum("ts,bse->bte", dft_seq_re, a) - torch.einsum("ts,bse->bte", dft_seq_im, b)
    return y
```

```asm
; @launch grid=(256,1,1) block=(320,1,1) lds=33792
.amdgcn_target "amdgcn-amd-amdhsa--gfx950"
.text
.globl standalone__spectral_fnet__prompt_kernel
.p2align 12
.fill 832, 4, 0xbf800000
.type standalone__spectral_fnet__prompt_kernel,@function
standalone__spectral_fnet__prompt_kernel:
s_load_dwordx16 s[16:31], s[0:1], 0
v_lshrrev_b32 v5, 6, v0
s_cmp_ge_u32 s2, 256
s_cbranch_scc1 Lend
v_readfirstlane_b32 s10, v5
s_getpc_b64 s[4:5]
Lpc:
v_min_u32 v6, (Lend-Lpc)>>6, v0
v_lshlrev_b32 v6, 6, v6
global_load_dword v229, v6, s[4:5]
s_mov_b32 s60, s2
s_sub_u32 s61, s2, 144
s_cmp_eq_u32 s10, 4
s_cselect_b32 s11, 255, s60
s_cselect_b32 s3, -1, 0
s_xor_b32 s12, s2, 224
s_and_b32 s3, s3, s12
s_and_b32 s4, s60, 15
s_lshr_b32 s5, s60, 4
s_mul_i32 s6, s4, 1152
s_lshl_b32 s7, s5, 7
s_add_u32 s7, s7, s6
v_bfe_u32 v6, v0, 3, 2
v_lshl_add_u32 v6, v5, 2, v6
v_lshlrev_b32 v7, 4, v0
v_and_b32 v7, 0x70, v7
v_and_b32 v8, 48, v0
v_lshlrev_b32 v18, 1, v8
v_xad_u32 v7, v7, v18, s7
s_movk_i32 s6, 18432
v_mad_u32_u24 v1, v6, s6, v7
v_and_b32 v6, 32, v0
s_movk_i32 s6, 9216
v_mad_u32_u24 v1, v6, s6, v1
v_add_u32 v2, 588800, v1
v_add_u32 v3, 1177600, v1
v_add_u32 v4, 1766400, v1
s_lshl_b32 s6, s10, 12
s_mov_b32 m0, s6
v_and_b32 v7, 0x3c, v0
v_lshlrev_b32 v18, 5, v7
v_and_b32 v7, 0x18, v0
v_lshl_add_u32 v18, v7, 2, v18
v_and_b32 v7, 3, v0
v_lshl_add_u32 v18, v7, 3, v18
v_xor_b32 v19, 64, v18
v_xor_b32 v132, 32, v18
v_xor_b32 v133, 96, v18
s_cmp_ge_u32 s11, 144
s_waitcnt lgkmcnt(0)
s_load_dword s13, s[30:31], 983040
s_cbranch_scc1 Lnp1
global_load_lds_dwordx4 v1, s[16:17] offset:0 nt
global_load_lds_dwordx4 v2, s[16:17] offset:1024 nt
global_load_lds_dwordx4 v3, s[16:17] offset:2048 nt
global_load_lds_dwordx4 v4, s[16:17] offset:3072 nt
v_and_b32 v7, 15, v0
v_lshl_add_u32 v7, v5, 5, v7
v_cmp_eq_u32 vcc, 1, v7
v_lshrrev_b32 v7, 1, v7
v_and_b32 v6, 1, v0
v_cvt_f32_u32 v71, v7
v_cvt_f32_u32 v70, v6
v_cvt_f32_u32 v8, v8
v_mul_f32 v71, 0x3c000000, v71
v_mul_f32 v70, 0x3e800000, v70
v_cndmask_b32_e64 v10, v71, 0.5, vcc
v_cndmask_b32_e64 v9, v70, 0, vcc
v_add_f32 v71, 0x3d800000, v71
v_fmac_f32 v9, v8, v10
v_fmac_f32 v70, v8, v71
v_add_f32 v16, v10, v10
v_add_f32 v68, v71, v71
v_cos_f32 v12, v9
v_add_f32 v9, v9, v10
v_cos_f32 v16, v16
v_cos_f32 v13, v9
v_add_f32 v9, v9, v10
v_cos_f32 v14, v9
v_add_f32 v9, v9, v10
v_cos_f32 v15, v9
v_add_f32 v16, v16, v16
v_cos_f32 v64, v70
v_add_f32 v70, v70, v71
v_cos_f32 v68, v68
v_cos_f32 v65, v70
v_add_f32 v70, v70, v71
v_cos_f32 v66, v70
v_add_f32 v70, v70, v71
v_cos_f32 v67, v70
v_add_f32 v68, v68, v68
v_lshlrev_b32 v11, 31, v7
v_lshrrev_b32 v8, 16, v11
v_or_b32 v11, v11, v8
v_cvt_pk_bf16_f32 v32, v12, v13
v_xor_b32 v34, v11, v32
v_cvt_pk_bf16_f32 v48, v64, v65
v_xor_b32 v50, v11, v48
v_cvt_pk_bf16_f32 v33, v14, v15
v_xor_b32 v35, v11, v33
v_cvt_pk_bf16_f32 v49, v66, v67
v_xor_b32 v51, v11, v49
v_pk_fma_f32 v[12:13], v[16:17], v[14:15], v[12:13] op_sel_hi:[0,1,1] neg_lo:[0,0,1] neg_hi:[0,0,1]
v_cvt_pk_bf16_f32 v36, v12, v13
v_xor_b32 v38, v11, v36
v_pk_fma_f32 v[64:65], v[68:69], v[66:67], v[64:65] op_sel_hi:[0,1,1] neg_lo:[0,0,1] neg_hi:[0,0,1]
v_cvt_pk_bf16_f32 v52, v64, v65
v_xor_b32 v54, v11, v52
v_pk_fma_f32 v[14:15], v[16:17], v[12:13], v[14:15] op_sel_hi:[0,1,1] neg_lo:[0,0,1] neg_hi:[0,0,1]
v_cvt_pk_bf16_f32 v37, v14, v15
v_xor_b32 v39, v11, v37
v_pk_fma_f32 v[66:67], v[68:69], v[64:65], v[66:67] op_sel_hi:[0,1,1] neg_lo:[0,0,1] neg_hi:[0,0,1]
v_cvt_pk_bf16_f32 v53, v66, v67
v_xor_b32 v55, v11, v53
v_pk_fma_f32 v[12:13], v[16:17], v[14:15], v[12:13] op_sel_hi:[0,1,1] neg_lo:[0,0,1] neg_hi:[0,0,1]
v_cvt_pk_bf16_f32 v40, v12, v13
v_xor_b32 v42, v11, v40
v_pk_fma_f32 v[64:65], v[68:69], v[66:67], v[64:65] op_sel_hi:[0,1,1] neg_lo:[0,0,1] neg_hi:[0,0,1]
v_cvt_pk_bf16_f32 v56, v64, v65
v_xor_b32 v58, v11, v56
v_pk_fma_f32 v[14:15], v[16:17], v[12:13], v[14:15] op_sel_hi:[0,1,1] neg_lo:[0,0,1] neg_hi:[0,0,1]
v_cvt_pk_bf16_f32 v41, v14, v15
v_xor_b32 v43, v11, v41
v_pk_fma_f32 v[66:67], v[68:69], v[64:65], v[66:67] op_sel_hi:[0,1,1] neg_lo:[0,0,1] neg_hi:[0,0,1]
v_cvt_pk_bf16_f32 v57, v66, v67
v_xor_b32 v59, v11, v57
v_pk_fma_f32 v[12:13], v[16:17], v[14:15], v[12:13] op_sel_hi:[0,1,1] neg_lo:[0,0,1] neg_hi:[0,0,1]
v_cvt_pk_bf16_f32 v44, v12, v13
v_xor_b32 v46, v11, v44
v_pk_fma_f32 v[64:65], v[68:69], v[66:67], v[64:65] op_sel_hi:[0,1,1] neg_lo:[0,0,1] neg_hi:[0,0,1]
v_cvt_pk_bf16_f32 v60, v64, v65
v_xor_b32 v62, v11, v60
v_pk_fma_f32 v[14:15], v[16:17], v[12:13], v[14:15] op_sel_hi:[0,1,1] neg_lo:[0,0,1] neg_hi:[0,0,1]
v_cvt_pk_bf16_f32 v45, v14, v15
v_xor_b32 v47, v11, v45
v_pk_fma_f32 v[66:67], v[68:69], v[64:65], v[66:67] op_sel_hi:[0,1,1] neg_lo:[0,0,1] neg_hi:[0,0,1]
v_cvt_pk_bf16_f32 v61, v66, v67
v_xor_b32 v63, v11, v61
Lnp1:
v_bfe_u32 v31, v0, 4, 2
v_and_b32 v230, 15, v0
v_cvt_f32_u32 v231, v230
v_mul_u32_u24 v228, 12, v31
v_cvt_f32_u32 v228, v228
s_cmp_eq_u32 s10, 4
s_cbranch_scc1 Lw4x
s_waitcnt lgkmcnt(0)
s_bitcmp1_b32 s13, 0
s_cselect_b32 s48, 0, 65537
s_mul_i32 s13, s13, 0x9E3779B1
s_add_u32 s13, s13, 0x7F4A7C15
s_mov_b32 s49, 65537
v_mov_b32 v232, s48
v_mov_b32 v220, s13
v_mov_b32 v221, s13
s_cmp_ge_u32 s11, 144
s_cbranch_scc1 Lnpb
s_lshl_b32 s7, s7, 1
s_add_u32 s7, s7, 2097152
v_lshl_add_u32 v6, v5, 3, v31
v_mul_u32_u24 v6, 73984, v6
v_lshl_add_u32 v7, v230, 4, s7
v_add_u32 v128, v6, v7
v_add_u32 v129, 36992, v128
v_add_u32 v130, 295936, v128
v_add_u32 v131, 332928, v128
s_lshr_b32 s9, s60, 3
s_lshl_b32 s5, s9, 7
s_and_b32 s9, s60, 7
s_lshl_b32 s9, s9, 2
s_add_u32 s5, s5, s9
s_add_u32 s5, s5, 1048576
v_and_b32 v7, 3, v0
v_lshl_add_u32 v7, v5, 2, v7
v_mul_u32_u24 v7, 2432, v7
v_add_u32 v20, s5, v7
s_cmp_gt_u32 s10, 0
s_cbranch_scc1 Lw0
s_waitcnt vmcnt(0)
Lw0:
s_barrier
ds_read_b64_tr_b16 v[64:65], v18 offset:0
ds_read_b64_tr_b16 v[66:67], v18 offset:2048
ds_read_b64_tr_b16 v[68:69], v19 offset:0
ds_read_b64_tr_b16 v[70:71], v19 offset:2048
ds_read_b64_tr_b16 v[72:73], v132 offset:0
ds_read_b64_tr_b16 v[74:75], v132 offset:2048
ds_read_b64_tr_b16 v[76:77], v133 offset:0
ds_read_b64_tr_b16 v[78:79], v133 offset:2048
s_waitcnt lgkmcnt(6)
v_mfma_f32_16x16x32_bf16 v[136:139], v[32:35], v[64:67], 0
s_waitcnt lgkmcnt(4)
v_mfma_f32_16x16x32_bf16 v[140:143], v[32:35], v[68:71], 0
s_waitcnt lgkmcnt(2)
v_mfma_f32_16x16x32_bf16 v[144:147], v[32:35], v[72:75], 0
s_waitcnt lgkmcnt(0)
v_mfma_f32_16x16x32_bf16 v[148:151], v[32:35], v[76:79], 0
s_cmp_gt_u32 s10, 1
s_cbranch_scc1 Lw1
s_waitcnt vmcnt(0)
Lw1:
s_barrier
v_mfma_f32_16x16x32_bf16 v[152:155], v[48:51], v[64:67], 0
ds_read_b64_tr_b16 v[80:81], v18 offset:4096
ds_read_b64_tr_b16 v[82:83], v18 offset:6144
v_mfma_f32_16x16x32_bf16 v[156:159], v[48:51], v[68:71], 0
ds_read_b64_tr_b16 v[84:85], v19 offset:4096
ds_read_b64_tr_b16 v[86:87], v19 offset:6144
v_mfma_f32_16x16x32_bf16 v[160:163], v[48:51], v[72:75], 0
ds_read_b64_tr_b16 v[88:89], v132 offset:4096
ds_read_b64_tr_b16 v[90:91], v132 offset:6144
v_mfma_f32_16x16x32_bf16 v[164:167], v[48:51], v[76:79], 0
ds_read_b64_tr_b16 v[92:93], v133 offset:4096
ds_read_b64_tr_b16 v[94:95], v133 offset:6144
s_cmp_gt_u32 s10, 2
s_cbranch_scc1 Lw2
s_waitcnt vmcnt(0)
Lw2:
s_barrier
s_waitcnt lgkmcnt(6)
v_mfma_f32_16x16x32_bf16 v[136:139], v[36:39], v[80:83], v[136:139]
ds_read_b64_tr_b16 v[96:97], v18 offset:8192
ds_read_b64_tr_b16 v[98:99], v18 offset:10240
s_waitcnt lgkmcnt(6)
v_mfma_f32_16x16x32_bf16 v[140:143], v[36:39], v[84:87], v[140:143]
ds_read_b64_tr_b16 v[100:101], v19 offset:8192
ds_read_b64_tr_b16 v[102:103], v19 offset:10240
s_waitcnt lgkmcnt(6)
v_mfma_f32_16x16x32_bf16 v[144:147], v[36:39], v[88:91], v[144:147]
ds_read_b64_tr_b16 v[104:105], v132 offset:8192
ds_read_b64_tr_b16 v[106:107], v132 offset:10240
s_waitcnt lgkmcnt(6)
v_mfma_f32_16x16x32_bf16 v[148:151], v[36:39], v[92:95], v[148:151]
s_mov_b64 exec, 15
global_atomic_swap v20, v220, s[30:31] sc1
s_mov_b64 exec, -1
ds_read_b64_tr_b16 v[108:109], v133 offset:8192
ds_read_b64_tr_b16 v[110:111], v133 offset:10240
s_waitcnt vmcnt(1)
s_barrier
s_waitcnt lgkmcnt(6)
v_mfma_f32_16x16x32_bf16 v[136:139], v[40:43], v[96:99], v[136:139]
ds_read_b64_tr_b16 v[112:113], v18 offset:12288
ds_read_b64_tr_b16 v[114:115], v18 offset:14336
s_waitcnt lgkmcnt(6)
v_mfma_f32_16x16x32_bf16 v[140:143], v[40:43], v[100:103], v[140:143]
ds_read_b64_tr_b16 v[116:117], v19 offset:12288
ds_read_b64_tr_b16 v[118:119], v19 offset:14336
s_waitcnt lgkmcnt(6)
v_mfma_f32_16x16x32_bf16 v[144:147], v[40:43], v[104:107], v[144:147]
ds_read_b64_tr_b16 v[120:121], v132 offset:12288
ds_read_b64_tr_b16 v[122:123], v132 offset:14336
s_waitcnt lgkmcnt(6)
v_mfma_f32_16x16x32_bf16 v[148:151], v[40:43], v[108:111], v[148:151]
ds_read_b64_tr_b16 v[124:125], v133 offset:12288
ds_read_b64_tr_b16 v[126:127], v133 offset:14336
s_waitcnt lgkmcnt(6)
v_mfma_f32_16x16x32_bf16 v[136:139], v[44:47], v[112:115], v[136:139]
s_waitcnt lgkmcnt(4)
v_mfma_f32_16x16x32_bf16 v[140:143], v[44:47], v[116:119], v[140:143]
s_waitcnt lgkmcnt(2)
v_mfma_f32_16x16x32_bf16 v[144:147], v[44:47], v[120:123], v[144:147]
s_waitcnt lgkmcnt(0)
v_mfma_f32_16x16x32_bf16 v[148:151], v[44:47], v[124:127], v[148:151]
v_mfma_f32_16x16x32_bf16 v[152:155], v[52:55], v[80:83], v[152:155]
v_mfma_f32_16x16x32_bf16 v[156:159], v[52:55], v[84:87], v[156:159]
v_cvt_pk_bf16_f32 v32, v136, v137
v_bfi_b32 v32, s49, v232, v32
v_mfma_f32_16x16x32_bf16 v[160:163], v[52:55], v[88:91], v[160:163]
v_cvt_pk_bf16_f32 v33, v140, v141
v_bfi_b32 v33, s49, v232, v33
v_mfma_f32_16x16x32_bf16 v[164:167], v[52:55], v[92:95], v[164:167]
v_cvt_pk_bf16_f32 v34, v144, v145
v_bfi_b32 v34, s49, v232, v34
v_mfma_f32_16x16x32_bf16 v[152:155], v[56:59], v[96:99], v[152:155]
v_cvt_pk_bf16_f32 v35, v148, v149
v_bfi_b32 v35, s49, v232, v35
v_mfma_f32_16x16x32_bf16 v[156:159], v[56:59], v[100:103], v[156:159]
global_store_dwordx4 v128, v[32:35], s[30:31] sc1
v_mfma_f32_16x16x32_bf16 v[160:163], v[56:59], v[104:107], v[160:163]
v_cvt_pk_bf16_f32 v36, v138, v139
v_bfi_b32 v36, s49, v232, v36
v_mfma_f32_16x16x32_bf16 v[164:167], v[56:59], v[108:111], v[164:167]
v_cvt_pk_bf16_f32 v37, v142, v143
v_bfi_b32 v37, s49, v232, v37
v_mfma_f32_16x16x32_bf16 v[152:155], v[60:63], v[112:115], v[152:155]
v_cvt_pk_bf16_f32 v38, v146, v147
v_bfi_b32 v38, s49, v232, v38
v_mfma_f32_16x16x32_bf16 v[156:159], v[60:63], v[116:119], v[156:159]
v_cvt_pk_bf16_f32 v39, v150, v151
v_bfi_b32 v39, s49, v232, v39
v_mfma_f32_16x16x32_bf16 v[160:163], v[60:63], v[120:123], v[160:163]
global_store_dwordx4 v129, v[36:39], s[30:31] sc1
v_mfma_f32_16x16x32_bf16 v[164:167], v[60:63], v[124:127], v[164:167]
v_cvt_pk_bf16_f32 v40, v152, v153
v_bfi_b32 v40, s49, v232, v40
v_cvt_pk_bf16_f32 v44, v154, v155
v_bfi_b32 v44, s49, v232, v44
v_cvt_pk_bf16_f32 v41, v156, v157
v_bfi_b32 v41, s49, v232, v41
v_cvt_pk_bf16_f32 v42, v160, v161
v_bfi_b32 v42, s49, v232, v42
v_cvt_pk_bf16_f32 v43, v164, v165
v_bfi_b32 v43, s49, v232, v43
global_store_dwordx4 v130, v[40:43], s[30:31] sc1
v_cvt_pk_bf16_f32 v45, v158, v159
v_bfi_b32 v45, s49, v232, v45
v_cvt_pk_bf16_f32 v46, v162, v163
v_bfi_b32 v46, s49, v232, v46
v_cvt_pk_bf16_f32 v47, v166, v167
v_bfi_b32 v47, s49, v232, v47
global_store_dwordx4 v131, v[44:47], s[30:31] sc1
s_branch Lgen
Lnpb:
s_barrier
s_barrier
s_barrier
s_barrier
s_cmp_lg_u32 s10, 0
s_cbranch_scc1 Lgen
s_add_u32 s5, s61, 144
s_lshr_b32 s4, s5, 3
s_lshl_b32 s4, s4, 7
s_and_b32 s5, s5, 7
s_lshl2_add_u32 s4, s5, s4
s_add_u32 s4, s4, 915200
v_mov_b32 v20, s4
s_mov_b64 exec, 1
global_atomic_swap v20, v220, s[30:31] sc1
s_mov_b64 exec, -1
Lgen:
s_and_b32 s4, s12, 7
s_lshr_b32 s5, s12, 2
s_and_b32 s5, s5, 0x38
s_mov_b32 s41, 0x03020100
s_or_b32 s14, s4, s5
s_cselect_b32 s41, s41, 0x0c0c0100
s_bfe_u32 s5, s12, 0x20003
s_lshl_b32 s40, s5, 9
s_add_u32 s40, s40, s14
s_andn2_b32 s6, s12, 8
s_cmp_eq_u32 s6, 16
s_cselect_b32 s41, 0x01000c0c, s41
s_cselect_b32 s6, 960, 0
s_sub_u32 s40, s40, s6
s_lshl_b32 s43, s10, 1
s_min_u32 s43, s43, 7
s_lshl_b32 s47, s10, 7
s_add_u32 s47, s47, s40
s_cmp_eq_u32 s10, 4
s_cselect_b32 s47, 1024, s47
s_movk_i32 s46, 30000
s_lshl_b32 s4, s43, 8
s_add_u32 s4, s4, 16384
v_lshl_add_u32 v7, v230, 2, s4
v_and_b32 v235, 2, v31
v_add_u32 v235, v235, v31
v_lshl_or_b32 v235, v235, 1, 1
v_mul_u32_u24 v8, 2304, v235
s_mul_i32 s4, s14, 36992
s_add_u32 s4, s4, 2080768
v_add3_u32 v22, v7, v8, s4
v_mad_u32_u24 v22, v230, 12, v22
v_add_u32 v23, 9216, v22
v_add_u32 v24, 4294964992, v22
v_add_u32 v25, 6912, v22
v_and_b32 v6, 16, v0
v_lshl_add_u32 v7, v6, 3, v7
v_and_b32 v6, 32, v0
v_mul_u32_u24 v6, 72, v6
v_add_u32 v26, v6, v7
v_add_u32 v238, 4608, v26
v_min_u32 v7, 11, v230
v_mul_u32_u24 v7, 12, v7
v_mul_u32_u24 v8, 576, v31
s_and_b32 s4, s10, 3
s_mul_i32 s4, s4, 2304
s_add_u32 s4, s4, 16384
v_add3_u32 v27, v7, v8, s4
v_add_u32 v7, 1, v31
v_and_b32 v7, 4, v7
v_lshl_add_u32 v28, v0, 2, v7
s_mul_i32 s4, s47, 1152
v_lshlrev_b32 v7, 5, v230
v_lshl_add_u32 v7, v31, 3, v7
v_add_u32 v29, s4, v7
v_sub_u32 v30, 2360440, v29
v_and_b32 v7, 1, v31
s_movk_i32 s4, 376
v_mad_u32_u24 v236, v7, s4, v29
v_sub_u32 v237, 2360432, v236
v_mov_b32 v222, 0
v_and_b32 v234, 63, v0
v_lshlrev_b32 v234, 4, v234
s_cmp_eq_u32 s12, 0
s_cselect_b32 vcc_lo, 0x00aa00aa, 0
s_mov_b32 vcc_hi, vcc_lo
v_lshrrev_b32 v7, 3, v230
v_lshl_add_u32 v7, v7, 7, s40
v_and_b32 v8, 1, v0
v_cvt_f32_u32 v10, v7
v_cvt_f32_u32 v9, v8
s_and_b32 s4, s10, 2
s_add_u32 s4, s4, s10
v_xor_b32 v8, s4, v235
v_cvt_f32_u32 v8, v8
v_mul_f32 v10, 0x3a000000, v10
v_mul_f32 v9, 0x3e800000, v9
v_add_f32 v11, 0x3e000000, v10
v_fma_f32 v6, v8, v11, v9
v_cndmask_b32_e64 v10, v10, 0.5, vcc
v_cndmask_b32_e64 v9, v9, 0, vcc
s_mov_b32 vcc_lo, 0x03030303
s_mov_b32 vcc_hi, vcc_lo
v_fmac_f32 v9, v8, v10
v_mov_b32 v7, s41
v_mov_b32 v8, 0x0c0c0c0c
v_cndmask_b32 v14, v8, v7, vcc
s_lshl_b64 vcc, vcc, 2
v_cndmask_b32 v16, v8, v7, vcc
s_lshl_b64 vcc, vcc, 2
v_cndmask_b32 v15, v8, v7, vcc
s_lshl_b64 vcc, vcc, 2
v_cndmask_b32 v17, v8, v7, vcc
v_cos_f32 v12, v9
v_sin_f32 v13, v9
v_cos_f32 v7, v6
v_sin_f32 v8, v6
v_lshlrev_b32 v6, 4, v0
v_cvt_pk_bf16_f32 v12, v12, v13
v_cvt_pk_bf16_f32 v7, v7, v8
v_perm_b32 v136, v12, v12, v14
v_perm_b32 v137, v12, v12, v15
v_perm_b32 v138, v12, v12, v16
v_perm_b32 v139, v12, v12, v17
ds_write_b128 v6, v[136:139] offset:25600
v_perm_b32 v140, v7, v7, v14
v_perm_b32 v141, v7, v7, v15
v_perm_b32 v142, v7, v7, v16
v_perm_b32 v143, v7, v7, v17
ds_write_b128 v6, v[140:143] offset:29696
Lgen2:
v_mul_f32 v10, 0x3d800000, v231
v_lshlrev_b32 v8, 2, v31
v_cvt_f32_u32 v8, v8
v_mul_f32 v9, v8, v10
v_cos_f32 v12, v9
v_sin_f32 v13, v9
v_add_f32 v9, v9, v10
v_cvt_pk_bf16_f32 v168, v12, v13
v_cvt_pk_bf16_f32 v172, -v13, v12
v_cos_f32 v12, v9
v_sin_f32 v13, v9
v_add_f32 v9, v9, v10
v_cvt_pk_bf16_f32 v169, v12, v13
v_cvt_pk_bf16_f32 v173, -v13, v12
v_cos_f32 v12, v9
v_sin_f32 v13, v9
v_add_f32 v9, v9, v10
v_cvt_pk_bf16_f32 v170, v12, v13
v_cvt_pk_bf16_f32 v174, -v13, v12
v_cos_f32 v12, v9
v_sin_f32 v13, v9
s_and_b32 s4, s10, 3
v_cvt_pk_bf16_f32 v171, v12, v13
v_cvt_pk_bf16_f32 v175, -v13, v12
s_or_b32 s4, s4, s12
s_cbranch_scc1 Lf16
s_cmp_eq_u32 s10, 0
s_cselect_b32 s4, 0, 16
s_mov_b32 s5, 0xffff
v_and_b32 v168, s5, v168
v_lshlrev_b32 v168, s4, v168
v_and_b32 v169, s5, v169
v_lshlrev_b32 v169, s4, v169
v_and_b32 v170, s5, v170
v_lshlrev_b32 v170, s4, v170
v_and_b32 v171, s5, v171
v_lshlrev_b32 v171, s4, v171
v_and_b32 v172, s5, v172
v_lshlrev_b32 v172, s4, v172
v_and_b32 v173, s5, v173
v_lshlrev_b32 v173, s4, v173
v_and_b32 v174, s5, v174
v_lshlrev_b32 v174, s4, v174
v_and_b32 v175, s5, v175
v_lshlrev_b32 v175, s4, v175
Lf16:
v_mul_f32 v10, 0x3ae38e39, v231
v_mul_f32 v9, v228, v10
v_cos_f32 v12, v10
v_sin_f32 v14, v10
v_cos_f32 v176, v9
v_sin_f32 v188, v9
v_fmamk_f32 v9, v10, 0x40400000, v9
v_cos_f32 v177, v9
v_sin_f32 v189, v9
v_fmamk_f32 v9, v10, 0x40400000, v9
v_cos_f32 v178, v9
v_sin_f32 v190, v9
v_fmamk_f32 v9, v10, 0x40400000, v9
v_cos_f32 v179, v9
v_sin_f32 v191, v9
v_add_f32 v16, v12, v12
s_mov_b32 exec_lo, 0
s_mov_b32 exec_hi, 0xffff0000
v_pk_mov_b32 v[176:177], 0, 0
v_pk_mov_b32 v[178:179], 0, 0
v_pk_mov_b32 v[188:189], 0, 0
v_pk_mov_b32 v[190:191], 0, 0
s_mov_b64 exec, -1
v_pk_mul_f32 v[180:181], v[12:13], v[176:177] op_sel_hi:[0,1]
v_pk_mul_f32 v[192:193], v[12:13], v[188:189] op_sel_hi:[0,1]
v_pk_mul_f32 v[182:183], v[12:13], v[178:179] op_sel_hi:[0,1]
v_pk_mul_f32 v[194:195], v[12:13], v[190:191] op_sel_hi:[0,1]
v_pk_fma_f32 v[180:181], v[14:15], v[188:189], v[180:181] op_sel_hi:[0,1,1] neg_lo:[1,0,0] neg_hi:[1,0,0]
v_pk_fma_f32 v[192:193], v[14:15], v[176:177], v[192:193] op_sel_hi:[0,1,1]
v_pk_fma_f32 v[182:183], v[14:15], v[190:191], v[182:183] op_sel_hi:[0,1,1] neg_lo:[1,0,0] neg_hi:[1,0,0]
v_pk_fma_f32 v[194:195], v[14:15], v[178:179], v[194:195] op_sel_hi:[0,1,1]
v_pk_fma_f32 v[184:185], v[16:17], v[180:181], v[176:177] op_sel_hi:[0,1,1] neg_lo:[0,0,1] neg_hi:[0,0,1]
v_pk_fma_f32 v[196:197], v[16:17], v[192:193], v[188:189] op_sel_hi:[0,1,1] neg_lo:[0,0,1] neg_hi:[0,0,1]
v_pk_fma_f32 v[186:187], v[16:17], v[182:183], v[178:179] op_sel_hi:[0,1,1] neg_lo:[0,0,1] neg_hi:[0,0,1]
v_pk_fma_f32 v[198:199], v[16:17], v[194:195], v[190:191] op_sel_hi:[0,1,1] neg_lo:[0,0,1] neg_hi:[0,0,1]
s_cmp_eq_u32 s10, 4
s_cbranch_scc1 Lb4s
s_setprio 1
s_waitcnt lgkmcnt(0)
s_barrier
global_load_dwordx4 v[32:35], v22, s[30:31] offset:0 sc1
ds_read_b128 v[136:139], v234 offset:25600
ds_read_b128 v[152:155], v234 offset:29696
v_mul_f32 v10, 0x3ce38e39, v231
v_mul_f32 v9, v228, v10
v_cos_f32 v12, v10
global_load_dwordx4 v[36:39], v23, s[30:31] offset:0 sc1
ds_read_b128 v[140:143], v234 offset:27648
ds_read_b128 v[156:159], v234 offset:31744
v_sin_f32 v14, v10
v_cos_f32 v112, v9
global_load_dwordx4 v[48:51], v22, s[30:31] offset:256 sc1
ds_read_b128 v[144:147], v234 offset:26624
ds_read_b128 v[160:163], v234 offset:30720
v_sin_f32 v124, v9
v_fmamk_f32 v9, v10, 0x40400000, v9
v_cos_f32 v113, v9
global_load_dwordx4 v[52:55], v23, s[30:31] offset:256 sc1
ds_read_b128 v[148:151], v234 offset:28672
ds_read_b128 v[164:167], v234 offset:32768
v_sin_f32 v125, v9
v_fmamk_f32 v9, v10, 0x40400000, v9
v_cos_f32 v114, v9
global_load_dwordx4 v[40:43], v24, s[30:31] offset:0 sc1
v_sin_f32 v126, v9
v_fmamk_f32 v9, v10, 0x40400000, v9
v_cos_f32 v115, v9
v_sin_f32 v127, v9
v_add_f32 v16, v12, v12
global_load_dwordx4 v[44:47], v25, s[30:31] offset:0 sc1
v_pk_mul_f32 v[116:117], v[12:13], v[112:113] op_sel_hi:[0,1]
v_pk_mul_f32 v[128:129], v[12:13], v[124:125] op_sel_hi:[0,1]
v_pk_mul_f32 v[118:119], v[12:13], v[114:115] op_sel_hi:[0,1]
v_pk_mul_f32 v[130:131], v[12:13], v[126:127] op_sel_hi:[0,1]
v_pk_fma_f32 v[116:117], v[14:15], v[124:125], v[116:117] op_sel_hi:[0,1,1] neg_lo:[1,0,0] neg_hi:[1,0,0]
v_pk_fma_f32 v[128:129], v[14:15], v[112:113], v[128:129] op_sel_hi:[0,1,1]
v_pk_fma_f32 v[118:119], v[14:15], v[126:127], v[118:119] op_sel_hi:[0,1,1] neg_lo:[1,0,0] neg_hi:[1,0,0]
v_pk_fma_f32 v[130:131], v[14:15], v[114:115], v[130:131] op_sel_hi:[0,1,1]
v_pk_fma_f32 v[120:121], v[16:17], v[116:117], v[112:113] op_sel_hi:[0,1,1] neg_lo:[0,0,1] neg_hi:[0,0,1]
v_pk_fma_f32 v[132:133], v[16:17], v[128:129], v[124:125] op_sel_hi:[0,1,1] neg_lo:[0,0,1] neg_hi:[0,0,1]
global_load_dwordx4 v[56:59], v24, s[30:31] offset:256 sc1
v_pk_fma_f32 v[122:123], v[16:17], v[118:119], v[114:115] op_sel_hi:[0,1,1] neg_lo:[0,0,1] neg_hi:[0,0,1]
v_pk_fma_f32 v[134:135], v[16:17], v[130:131], v[126:127] op_sel_hi:[0,1,1] neg_lo:[0,0,1] neg_hi:[0,0,1]
v_cvt_pk_bf16_f32 v200, v112, v113
v_cvt_pk_bf16_f32 v202, v124, v125
v_cvt_pk_bf16_f32 v201, v114, v115
v_cvt_pk_bf16_f32 v203, v126, v127
v_cvt_pk_bf16_f32 v204, v116, v117
v_cvt_pk_bf16_f32 v206, v128, v129
v_cvt_pk_bf16_f32 v205, v118, v119
v_cvt_pk_bf16_f32 v207, v130, v131
global_load_dwordx4 v[60:63], v25, s[30:31] offset:256 sc1
v_cvt_pk_bf16_f32 v208, v120, v121
v_cvt_pk_bf16_f32 v210, v132, v133
v_cvt_pk_bf16_f32 v209, v122, v123
v_cvt_pk_bf16_f32 v211, v134, v135
v_mov_b32 v16, 0x3f5db3d7
v_pk_mul_f32 v[116:117], v[16:17], v[116:117] op_sel_hi:[0,1]
v_pk_mul_f32 v[128:129], v[16:17], v[128:129] op_sel_hi:[0,1]
v_pk_mul_f32 v[118:119], v[16:17], v[118:119] op_sel_hi:[0,1]
v_pk_mul_f32 v[130:131], v[16:17], v[130:131] op_sel_hi:[0,1]
v_pk_mul_f32 v[120:121], v[16:17], v[120:121] op_sel_hi:[0,1]
v_pk_mul_f32 v[132:133], v[16:17], v[132:133] op_sel_hi:[0,1]
v_pk_mul_f32 v[122:123], v[16:17], v[122:123] op_sel_hi:[0,1]
v_pk_mul_f32 v[134:135], v[16:17], v[134:135] op_sel_hi:[0,1]
v_cvt_pk_bf16_f32 v212, -v128, -v129
v_cvt_pk_bf16_f32 v214, v116, v117
v_cvt_pk_bf16_f32 v213, -v130, -v131
v_cvt_pk_bf16_f32 v215, v118, v119
v_cvt_pk_bf16_f32 v216, v132, v133
v_cvt_pk_bf16_f32 v218, -v120, -v121
v_cvt_pk_bf16_f32 v217, v134, v135
v_cvt_pk_bf16_f32 v219, -v122, -v123
Lj:
v_mov_b32 v233, 0
s_cmp_eq_u32 s10, 4
s_cbranch_scc0 La0
s_waitcnt vmcnt(2) lgkmcnt(0)
s_branch La1
La0:
s_waitcnt vmcnt(7) lgkmcnt(0)
v_mfma_f32_16x16x32_bf16 v[80:83], v[136:139], v[32:35], 0
v_bitop3_b32 v233, v233, v32, s48 bitop3:0xf6
v_bitop3_b32 v233, v233, v33, s48 bitop3:0xf6
v_mfma_f32_16x16x32_bf16 v[84:87], v[152:155], v[32:35], 0
v_bitop3_b32 v233, v233, v34, s48 bitop3:0xf6
v_bitop3_b32 v233, v233, v35, s48 bitop3:0xf6
s_waitcnt vmcnt(6)
v_mfma_f32_16x16x32_bf16 v[80:83], v[140:143], v[36:39], v[80:83]
v_bitop3_b32 v233, v233, v36, s48 bitop3:0xf6
v_bitop3_b32 v233, v233, v37, s48 bitop3:0xf6
v_mfma_f32_16x16x32_bf16 v[84:87], v[156:159], v[36:39], v[84:87]
v_bitop3_b32 v233, v233, v38, s48 bitop3:0xf6
v_bitop3_b32 v233, v233, v39, s48 bitop3:0xf6
La1:
s_waitcnt vmcnt(5)
v_mfma_f32_16x16x32_bf16 v[88:91], v[136:139], v[48:51], 0
v_bitop3_b32 v233, v233, v48, s48 bitop3:0xf6
v_bitop3_b32 v233, v233, v49, s48 bitop3:0xf6
v_mfma_f32_16x16x32_bf16 v[92:95], v[152:155], v[48:51], 0
v_bitop3_b32 v233, v233, v50, s48 bitop3:0xf6
v_bitop3_b32 v233, v233, v51, s48 bitop3:0xf6
s_waitcnt vmcnt(4)
v_mfma_f32_16x16x32_bf16 v[88:91], v[140:143], v[52:55], v[88:91]
v_bitop3_b32 v233, v233, v52, s48 bitop3:0xf6
v_bitop3_b32 v233, v233, v53, s48 bitop3:0xf6
v_mfma_f32_16x16x32_bf16 v[92:95], v[156:159], v[52:55], v[92:95]
v_bitop3_b32 v233, v233, v54, s48 bitop3:0xf6
v_bitop3_b32 v233, v233, v55, s48 bitop3:0xf6
s_cbranch_scc1 La2
s_waitcnt vmcnt(3)
v_mfma_f32_16x16x32_bf16 v[80:83], v[144:147], v[40:43], v[80:83]
v_bitop3_b32 v233, v233, v40, s48 bitop3:0xf6
v_bitop3_b32 v233, v233, v41, s48 bitop3:0xf6
v_mfma_f32_16x16x32_bf16 v[84:87], v[160:163], v[40:43], v[84:87]
v_bitop3_b32 v233, v233, v42, s48 bitop3:0xf6
v_bitop3_b32 v233, v233, v43, s48 bitop3:0xf6
s_waitcnt vmcnt(2)
v_mfma_f32_16x16x32_bf16 v[80:83], v[148:151], v[44:47], v[80:83]
v_bitop3_b32 v233, v233, v44, s48 bitop3:0xf6
v_bitop3_b32 v233, v233, v45, s48 bitop3:0xf6
v_mfma_f32_16x16x32_bf16 v[84:87], v[164:167], v[44:47], v[84:87]
v_bitop3_b32 v233, v233, v46, s48 bitop3:0xf6
v_bitop3_b32 v233, v233, v47, s48 bitop3:0xf6
La2:
s_waitcnt vmcnt(1)
v_mfma_f32_16x16x32_bf16 v[88:91], v[144:147], v[56:59], v[88:91]
v_bitop3_b32 v233, v233, v56, s48 bitop3:0xf6
v_bitop3_b32 v233, v233, v57, s48 bitop3:0xf6
v_mfma_f32_16x16x32_bf16 v[92:95], v[160:163], v[56:59], v[92:95]
v_bitop3_b32 v233, v233, v58, s48 bitop3:0xf6
v_bitop3_b32 v233, v233, v59, s48 bitop3:0xf6
s_cbranch_scc1 La3
v_cvt_pk_bf16_f32 v104, v80, v81
v_cvt_pk_bf16_f32 v105, v82, v83
ds_write2_b32 v26, v104, v105 offset0:0 offset1:16
v_cvt_pk_bf16_f32 v106, v84, v85
v_cvt_pk_bf16_f32 v107, v86, v87
ds_write2_b32 v238, v106, v107 offset0:0 offset1:16
La3:
s_waitcnt vmcnt(0)
v_mfma_f32_16x16x32_bf16 v[88:91], v[148:151], v[60:63], v[88:91]
v_bitop3_b32 v233, v233, v60, s48 bitop3:0xf6
v_bitop3_b32 v233, v233, v61, s48 bitop3:0xf6
v_mfma_f32_16x16x32_bf16 v[92:95], v[164:167], v[60:63], v[92:95]
v_bitop3_b32 v233, v233, v62, s48 bitop3:0xf6
v_bitop3_b32 v233, v233, v63, s48 bitop3:0xf6
v_and_b32 v233, s49, v233
v_cmp_ne_u32 vcc, 0, v233
s_cmp_lg_u32 s3, 0
v_cvt_pk_bf16_f32 v108, v88, v89
v_cvt_pk_bf16_f32 v109, v90, v91
s_cbranch_vccnz Lrt
Lok:
v_cvt_pk_bf16_f32 v110, v92, v93
v_cvt_pk_bf16_f32 v111, v94, v95
ds_write2_b32 v26, v108, v109 offset0:64 offset1:80
ds_write2_b32 v238, v110, v111 offset0:64 offset1:80
s_cbranch_scc1 Laux
s_waitcnt lgkmcnt(0)
s_barrier
ds_read2_b32 v[36:37], v27 offset0:1 offset1:37
ds_read2_b32 v[38:39], v27 offset0:73 offset1:109
ds_read2_b32 v[40:41], v27 offset0:2 offset1:38
ds_read2_b32 v[42:43], v27 offset0:74 offset1:110
ds_read2_b32 v[32:33], v27 offset0:0 offset1:36
ds_read2_b32 v[34:35], v27 offset0:72 offset1:108
s_cmp_eq_u32 s10, 4
s_cbranch_scc0 Lnoep
v_mov_b32 v7, 983040
s_mov_b64 exec, 1
global_store_dword v7, v220, s[30:31] sc1
s_mov_b64 exec, -1
Lnoep:
s_waitcnt lgkmcnt(4)
v_mfma_f32_16x16x32_bf16 v[48:51], v[36:39], v[168:171], 0
v_mfma_f32_16x16x32_bf16 v[60:63], v[36:39], v[172:175], 0
s_waitcnt lgkmcnt(2)
v_mfma_f32_16x16x32_bf16 v[52:55], v[40:43], v[168:171], 0
v_mfma_f32_16x16x32_bf16 v[64:67], v[40:43], v[172:175], 0
s_waitcnt lgkmcnt(0)
v_mfma_f32_16x16x32_bf16 v[44:47], v[32:35], v[168:171], 0
v_mov_b32 v16, 0xbfc00000
s_and_b32 s4, s47, 1023
v_mfma_f32_16x16x32_bf16 v[56:59], v[32:35], v[172:175], 0
v_mul_f32 v76, v48, v180
v_mul_f32 v77, v49, v181
v_mul_f32 v80, v60, v180
v_mul_f32 v81, v61, v181
v_pk_mul_f32 v[78:79], v[50:51], v[182:183]
v_pk_mul_f32 v[82:83], v[62:63], v[182:183]
v_pk_fma_f32 v[76:77], v[60:61], v[192:193], v[76:77]
v_pk_fma_f32 v[80:81], v[48:49], v[192:193], v[80:81] neg_lo:[1,0,0] neg_hi:[1,0,0]
v_pk_fma_f32 v[78:79], v[62:63], v[194:195], v[78:79]
v_pk_fma_f32 v[82:83], v[50:51], v[194:195], v[82:83] neg_lo:[1,0,0] neg_hi:[1,0,0]
v_pk_mul_f32 v[84:85], v[52:53], v[184:185]
v_pk_mul_f32 v[88:89], v[64:65], v[184:185]
v_pk_mul_f32 v[86:87], v[54:55], v[186:187]
v_pk_mul_f32 v[90:91], v[66:67], v[186:187]
v_pk_fma_f32 v[84:85], v[64:65], v[196:197], v[84:85]
v_pk_fma_f32 v[88:89], v[52:53], v[196:197], v[88:89] neg_lo:[1,0,0] neg_hi:[1,0,0]
v_pk_fma_f32 v[86:87], v[66:67], v[198:199], v[86:87]
v_pk_fma_f32 v[90:91], v[54:55], v[198:199], v[90:91] neg_lo:[1,0,0] neg_hi:[1,0,0]
v_pk_mul_f32 v[68:69], v[44:45], v[176:177]
v_pk_mul_f32 v[72:73], v[56:57], v[176:177]
v_pk_mul_f32 v[70:71], v[46:47], v[178:179]
v_pk_mul_f32 v[74:75], v[58:59], v[178:179]
v_pk_fma_f32 v[68:69], v[56:57], v[188:189], v[68:69]
v_pk_fma_f32 v[72:73], v[44:45], v[188:189], v[72:73] neg_lo:[1,0,0] neg_hi:[1,0,0]
v_pk_fma_f32 v[70:71], v[58:59], v[190:191], v[70:71]
v_pk_fma_f32 v[74:75], v[46:47], v[190:191], v[74:75] neg_lo:[1,0,0] neg_hi:[1,0,0]
v_cvt_pk_bf16_f32 v96, v76, v77
v_cvt_pk_bf16_f32 v97, v78, v79
v_cvt_pk_bf16_f32 v98, v80, v81
v_cvt_pk_bf16_f32 v99, v82, v83
v_cvt_pk_bf16_f32 v100, v84, v85
v_cvt_pk_bf16_f32 v101, v86, v87
v_mfma_f32_16x16x32_bf16 v[132:135], v[96:99], v[204:207], 0
v_cvt_pk_bf16_f32 v102, v88, v89
v_cvt_pk_bf16_f32 v103, v90, v91
v_mfma_f32_16x16x32_bf16 v[136:139], v[96:99], v[212:215], 0
v_cvt_pk_bf16_f32 v92, v68, v69
v_cvt_pk_bf16_f32 v93, v70, v71
v_mfma_f32_16x16x32_bf16 v[132:135], v[100:103], v[208:211], v[132:135]
v_cvt_pk_bf16_f32 v94, v72, v73
v_cvt_pk_bf16_f32 v95, v74, v75
v_mfma_f32_16x16x32_bf16 v[136:139], v[100:103], v[216:219], v[136:139]
s_mov_b32 s6, 0x0fff0fff
s_mov_b32 s7, 0x0fff0fff
v_mfma_f32_16x16x32_bf16 v[104:107], v[92:95], v[200:203], v[132:135]
s_nop 4
v_pk_fma_f32 v[108:109], v[16:17], v[132:133], v[136:137] op_sel_hi:[0,1,1]
v_pk_fma_f32 v[110:111], v[16:17], v[134:135], v[138:139] op_sel_hi:[0,1,1]
v_pk_fma_f32 v[112:113], v[16:17], v[132:133], v[136:137] op_sel_hi:[0,1,1] neg_lo:[0,0,1] neg_hi:[0,0,1]
v_pk_fma_f32 v[114:115], v[16:17], v[134:135], v[138:139] op_sel_hi:[0,1,1] neg_lo:[0,0,1] neg_hi:[0,0,1]
v_pk_add_f32 v[108:109], v[104:105], v[108:109]
v_pk_add_f32 v[110:111], v[106:107], v[110:111]
v_pk_add_f32 v[112:113], v[104:105], v[112:113]
v_pk_add_f32 v[114:115], v[106:107], v[114:115]
ds_bpermute_b32 v128, v28, v104 offset:64
ds_bpermute_b32 v129, v28, v108 offset:64
ds_bpermute_b32 v130, v28, v112 offset:64
v_cvt_pk_bf16_f32 v116, v104, v105
v_cvt_pk_bf16_f32 v118, v108, v109
v_cvt_pk_bf16_f32 v117, v106, v107
v_cvt_pk_bf16_f32 v119, v110, v111
v_permlane16_swap_b32 v116, v118
v_cvt_pk_bf16_f32 v120, v112, v113
v_permlane16_swap_b32 v117, v119
v_cvt_pk_bf16_f32 v121, v114, v115
s_mov_b64 exec, s[6:7]
global_store_dwordx4 v236, v[116:119], s[26:27] sc1
global_store_dwordx2 v29, v[120:121], s[26:27] offset:768 sc1
s_cbranch_scc0 Lrow0
v_cvt_pk_bf16_f32 v127, v106, v105
v_cvt_pk_bf16_f32 v125, v110, v109
v_cvt_pk_bf16_f32 v123, v114, v113
s_waitcnt lgkmcnt(0)
v_cvt_pk_bf16_f32 v126, v128, v107
v_cvt_pk_bf16_f32 v124, v129, v111
v_permlane16_swap_b32 v127, v125
v_cvt_pk_bf16_f32 v122, v130, v115
v_permlane16_swap_b32 v126, v124
global_store_dwordx4 v237, v[124:127], s[26:27] sc1
global_store_dwordx2 v30, v[122:123], s[26:27] offset:-768 sc1
Lrow0:
Lfin:
s_endpgm
Laux:
s_waitcnt lgkmcnt(0)
s_barrier
s_endpgm
Lb4s:
v_mul_f32 v10, 0x3ce38e39, v231
v_mul_f32 v9, v228, v10
v_cos_f32 v12, v10
v_sin_f32 v14, v10
v_cos_f32 v112, v9
v_sin_f32 v124, v9
v_fmamk_f32 v9, v10, 0x40400000, v9
v_cos_f32 v113, v9
v_sin_f32 v125, v9
v_fmamk_f32 v9, v10, 0x40400000, v9
v_cos_f32 v114, v9
v_sin_f32 v126, v9
v_fmamk_f32 v9, v10, 0x40400000, v9
v_cos_f32 v115, v9
v_sin_f32 v127, v9
v_add_f32 v16, v12, v12
v_pk_mul_f32 v[116:117], v[12:13], v[112:113] op_sel_hi:[0,1]
v_pk_mul_f32 v[128:129], v[12:13], v[124:125] op_sel_hi:[0,1]
v_pk_mul_f32 v[118:119], v[12:13], v[114:115] op_sel_hi:[0,1]
v_pk_mul_f32 v[130:131], v[12:13], v[126:127] op_sel_hi:[0,1]
v_pk_fma_f32 v[116:117], v[14:15], v[124:125], v[116:117] op_sel_hi:[0,1,1] neg_lo:[1,0,0] neg_hi:[1,0,0]
v_pk_fma_f32 v[128:129], v[14:15], v[112:113], v[128:129] op_sel_hi:[0,1,1]
v_pk_fma_f32 v[118:119], v[14:15], v[126:127], v[118:119] op_sel_hi:[0,1,1] neg_lo:[1,0,0] neg_hi:[1,0,0]
v_pk_fma_f32 v[130:131], v[14:15], v[114:115], v[130:131] op_sel_hi:[0,1,1]
v_pk_fma_f32 v[120:121], v[16:17], v[116:117], v[112:113] op_sel_hi:[0,1,1] neg_lo:[0,0,1] neg_hi:[0,0,1]
v_pk_fma_f32 v[132:133], v[16:17], v[128:129], v[124:125] op_sel_hi:[0,1,1] neg_lo:[0,0,1] neg_hi:[0,0,1]
v_pk_fma_f32 v[122:123], v[16:17], v[118:119], v[114:115] op_sel_hi:[0,1,1] neg_lo:[0,0,1] neg_hi:[0,0,1]
v_pk_fma_f32 v[134:135], v[16:17], v[130:131], v[126:127] op_sel_hi:[0,1,1] neg_lo:[0,0,1] neg_hi:[0,0,1]
v_cvt_pk_bf16_f32 v200, v112, v113
v_cvt_pk_bf16_f32 v202, v124, v125
v_cvt_pk_bf16_f32 v201, v114, v115
v_cvt_pk_bf16_f32 v203, v126, v127
v_cvt_pk_bf16_f32 v204, v116, v117
v_cvt_pk_bf16_f32 v206, v128, v129
v_cvt_pk_bf16_f32 v205, v118, v119
v_cvt_pk_bf16_f32 v207, v130, v131
v_cvt_pk_bf16_f32 v208, v120, v121
v_cvt_pk_bf16_f32 v210, v132, v133
v_cvt_pk_bf16_f32 v209, v122, v123
v_cvt_pk_bf16_f32 v211, v134, v135
v_mov_b32 v16, 0x3f5db3d7
v_pk_mul_f32 v[116:117], v[16:17], v[116:117] op_sel_hi:[0,1]
v_pk_mul_f32 v[128:129], v[16:17], v[128:129] op_sel_hi:[0,1]
v_pk_mul_f32 v[118:119], v[16:17], v[118:119] op_sel_hi:[0,1]
v_pk_mul_f32 v[130:131], v[16:17], v[130:131] op_sel_hi:[0,1]
v_pk_mul_f32 v[120:121], v[16:17], v[120:121] op_sel_hi:[0,1]
v_pk_mul_f32 v[132:133], v[16:17], v[132:133] op_sel_hi:[0,1]
v_pk_mul_f32 v[122:123], v[16:17], v[122:123] op_sel_hi:[0,1]
v_pk_mul_f32 v[134:135], v[16:17], v[134:135] op_sel_hi:[0,1]
v_cvt_pk_bf16_f32 v212, -v128, -v129
v_cvt_pk_bf16_f32 v214, v116, v117
v_cvt_pk_bf16_f32 v213, -v130, -v131
v_cvt_pk_bf16_f32 v215, v118, v119
v_cvt_pk_bf16_f32 v216, v132, v133
v_cvt_pk_bf16_f32 v218, -v120, -v121
v_cvt_pk_bf16_f32 v217, v134, v135
v_cvt_pk_bf16_f32 v219, -v122, -v123
s_branch Lb4
Lw4x:
s_and_b32 s4, s12, 7
s_lshr_b32 s5, s12, 2
s_and_b32 s5, s5, 0x38
s_mov_b32 s41, 0x03020100
s_or_b32 s14, s4, s5
s_cselect_b32 s41, s41, 0x0c0c0100
s_bfe_u32 s5, s12, 0x20003
s_lshl_b32 s40, s5, 9
s_add_u32 s40, s40, s14
s_andn2_b32 s6, s12, 8
s_cmp_eq_u32 s6, 16
s_cselect_b32 s41, 0x01000c0c, s41
s_cselect_b32 s6, 960, 0
s_sub_u32 s40, s40, s6
s_lshl_b32 s43, s10, 1
s_min_u32 s43, s43, 7
s_lshl_b32 s47, s10, 7
s_add_u32 s47, s47, s40
s_cmp_eq_u32 s10, 4
s_cselect_b32 s47, 1024, s47
s_movk_i32 s46, 30000
s_lshl_b32 s4, s43, 8
s_add_u32 s4, s4, 16384
v_lshl_add_u32 v7, v230, 2, s4
v_and_b32 v235, 2, v31
v_add_u32 v235, v235, v31
v_lshl_or_b32 v235, v235, 1, 1
v_mul_u32_u24 v8, 2304, v235
s_mul_i32 s4, s14, 36992
s_add_u32 s4, s4, 2080768
v_add3_u32 v22, v7, v8, s4
v_mad_u32_u24 v22, v230, 12, v22
v_add_u32 v23, 9216, v22
v_add_u32 v24, 4294964992, v22
v_add_u32 v25, 6912, v22
v_and_b32 v6, 16, v0
v_lshl_add_u32 v7, v6, 3, v7
v_and_b32 v6, 32, v0
v_mul_u32_u24 v6, 72, v6
v_add_u32 v26, v6, v7
v_add_u32 v238, 4608, v26
v_min_u32 v7, 11, v230
v_mul_u32_u24 v7, 12, v7
v_mul_u32_u24 v8, 576, v31
s_and_b32 s4, s10, 3
s_mul_i32 s4, s4, 2304
s_add_u32 s4, s4, 16384
v_add3_u32 v27, v7, v8, s4
v_add_u32 v7, 1, v31
v_and_b32 v7, 4, v7
v_lshl_add_u32 v28, v0, 2, v7
s_mul_i32 s4, s47, 1152
v_lshlrev_b32 v7, 5, v230
v_lshl_add_u32 v7, v31, 3, v7
v_add_u32 v29, s4, v7
v_sub_u32 v30, 2360440, v29
v_and_b32 v7, 1, v31
s_movk_i32 s4, 376
v_mad_u32_u24 v236, v7, s4, v29
v_sub_u32 v237, 2360432, v236
v_mov_b32 v222, 0
v_and_b32 v234, 63, v0
v_lshlrev_b32 v234, 4, v234
s_waitcnt lgkmcnt(0)
s_bitcmp1_b32 s13, 0
s_cselect_b32 s48, 0, 65537
s_mul_i32 s13, s13, 0x9E3779B1
s_add_u32 s13, s13, 0x7F4A7C15
s_mov_b32 s49, 65537
v_mov_b32 v232, s48
v_mov_b32 v220, s13
v_mov_b32 v221, s13
s_cmp_eq_u32 s3, 0
s_cbranch_scc1 Lgen2
Lb4:
s_bfe_u32 s6, s2, 0x40002
s_mul_i32 s6, s6, 2432
s_add_u32 s6, s6, 1048576
v_bfe_u32 v2, v0, 2, 4
v_and_b32 v1, 3, v0
v_lshl_add_u32 v2, v2, 7, s6
v_lshl_add_u32 v1, v1, 3, v2
v_mov_b32 v223, 0
s_mov_b64 s[52:53], -1
v_mov_b32 v3, v1
s_andn2_b64 exec, -1, 0xff
v_subrev_u32 v3, 152832, v1
s_cmp_eq_u32 s3, 0
s_cselect_b64 s[54:55], -1, 0xff
s_setprio 3
s_barrier
s_barrier
s_barrier
s_mov_b64 exec, s[52:53]
global_atomic_or_x2 v[96:97], v1, v[222:223], s[30:31] offset:0 sc0 sc1
s_mov_b64 exec, s[54:55]
global_atomic_or_x2 v[98:99], v3, v[222:223], s[30:31] offset:2048 sc0 sc1
s_barrier
Lp1f:
Lpl:
s_waitcnt vmcnt(1)
s_mov_b64 exec, s[52:53]
v_cmp_ne_u64 s[52:53], v[220:221], v[96:97]
s_waitcnt vmcnt(0)
s_mov_b64 exec, s[54:55]
v_cmp_ne_u64 s[54:55], v[220:221], v[98:99]
s_or_b64 s[4:5], s[52:53], s[54:55]
s_cbranch_scc0 Lpd
s_mov_b64 exec, s[52:53]
global_atomic_or_x2 v[96:97], v1, v[222:223], s[30:31] offset:0 sc0 sc1
s_mov_b64 exec, s[54:55]
global_atomic_or_x2 v[98:99], v3, v[222:223], s[30:31] offset:2048 sc0 sc1
s_sub_u32 s46, s46, 1
s_cbranch_scc0 Lpl
Lpd:
s_mov_b64 exec, -1
global_load_dwordx4 v[48:51], v22, s[30:31] offset:256 sc1
global_load_dwordx4 v[52:55], v23, s[30:31] offset:256 sc1
global_load_dwordx4 v[56:59], v24, s[30:31] offset:256 sc1
global_load_dwordx4 v[60:63], v25, s[30:31] offset:256 sc1
s_barrier
ds_read_b128 v[136:139], v234 offset:25600
ds_read_b128 v[152:155], v234 offset:29696
ds_read_b128 v[140:143], v234 offset:27648
ds_read_b128 v[156:159], v234 offset:31744
ds_read_b128 v[144:147], v234 offset:26624
ds_read_b128 v[160:163], v234 offset:30720
ds_read_b128 v[148:151], v234 offset:28672
ds_read_b128 v[164:167], v234 offset:32768
s_movk_i32 s46, 20000
s_setprio 0
s_branch Lj
Lrt:
s_sub_u32 s46, s46, 1
s_cbranch_scc0 Lre
s_cmp_lg_u32 s3, 0
s_branch Lok
Lre:
s_cmp_eq_u32 s10, 4
s_cbranch_scc1 Lr4
global_load_dwordx4 v[32:35], v22, s[30:31] offset:0 sc1
global_load_dwordx4 v[36:39], v23, s[30:31] offset:0 sc1
global_load_dwordx4 v[48:51], v22, s[30:31] offset:256 sc1
global_load_dwordx4 v[52:55], v23, s[30:31] offset:256 sc1
global_load_dwordx4 v[40:43], v24, s[30:31] offset:0 sc1
global_load_dwordx4 v[44:47], v25, s[30:31] offset:0 sc1
global_load_dwordx4 v[56:59], v24, s[30:31] offset:256 sc1
global_load_dwordx4 v[60:63], v25, s[30:31] offset:256 sc1
s_branch Lj
Lr4:
global_load_dwordx4 v[48:51], v22, s[30:31] offset:256 sc1
global_load_dwordx4 v[52:55], v23, s[30:31] offset:256 sc1
global_load_dwordx4 v[56:59], v24, s[30:31] offset:256 sc1
global_load_dwordx4 v[60:63], v25, s[30:31] offset:256 sc1
s_branch Lj
Lend:
s_endpgm
.section .rodata,"a"
.p2align 6
.amdhsa_kernel standalone__spectral_fnet__prompt_kernel
  .amdhsa_next_free_vgpr 240
  .amdhsa_next_free_sgpr 96
  .amdhsa_accum_offset 240
  .amdhsa_group_segment_fixed_size 0
  .amdhsa_kernarg_size 64
  .amdhsa_user_sgpr_count 2
  .amdhsa_user_sgpr_kernarg_segment_ptr 1
  .amdhsa_system_sgpr_workgroup_id_x 1
.end_amdhsa_kernel
```
